```python
import torch

def _softmax(x, axis=-1):
    return torch.softmax(x, dim=axis)
def _gelu(x):
    return torch.nn.functional.gelu(x, approximate="tanh")
def _silu(x):
    return torch.nn.functional.silu(x)
def _sigmoid(x):
    return torch.sigmoid(x)
def _layernorm(x, axis=-1, eps=1e-5):
    m = x.mean(dim=axis, keepdim=True)
    v = x.var(dim=axis, keepdim=True, unbiased=False)
    return (x - m) / torch.sqrt(v + eps)
def _scatter_add(tgt, idx, src, axis=0):
    return tgt.clone().index_add_(axis, idx, src)
def _segment_sum(src, seg, n):
    out = torch.zeros((n,) + src.shape[1:], dtype=src.dtype)
    return out.index_add_(0, seg, src)
def _pad(x, pw):
    flat = tuple(v for pair in reversed(pw) for v in pair)
    return torch.nn.functional.pad(x, flat)

kernel_name = 'standalone__grn__sampling'

def setup_inputs():

    _w = (lambda a: (lambda t: t.to(torch.bfloat16) if t.is_floating_point() else t)(torch.as_tensor(a)))
    B, S, D = 1024, 32, 448
    return {
        "x": _w((lambda *s: torch.randn(*s, dtype=torch.bfloat16) * 0.05)(B, S, D)),
        "g": _w((lambda *s: torch.randn(*s, dtype=torch.bfloat16) * 0.4)(D) * 0.1),
        "b": _w((lambda *s: torch.randn(*s, dtype=torch.bfloat16) * 0.1)(D) * 0.1),
    }

def reference(x, g, b):
    gx = torch.sqrt((x * x).sum(axis=-2, keepdims=True))
    nx = gx / (gx.mean(axis=-1, keepdims=True) + 1e-6)
    return g * (x * nx) + b + x
```

```asm
; @launch grid=(1024,1,1) block=(256,1,1) lds=7168
.amdgcn_target "amdgcn-amd-amdhsa--gfx950"
.text
.globl standalone__grn__sampling_kernel
.p2align 8
.type standalone__grn__sampling_kernel,@function
standalone__grn__sampling_kernel:
    s_cmp_ge_u32 s2, 1024
    s_cbranch_scc1 L_end
    s_load_dwordx8 s[4:11], s[0:1], 0
    v_and_b32 v2, 63, v0
    v_lshlrev_b32 v2, 4, v2
    s_mul_i32 s3, s2, 28672
    v_lshrrev_b32 v7, 6, v0
    v_mul_u32_u24 v1, 7168, v7
    v_mul_u32_u24 v5, 1792, v7
    v_add3_u32 v1, v1, v2, s3
    v_add_u32 v5, v5, v2
    v_mov_b32 v3, 0
    v_mov_b32 v4, 0x3b124925
    s_mov_b32 s31, 3584
    s_mov_b32 exec_lo, -1
    s_mov_b32 exec_hi, 0x00ffffff
    s_setprio 3
    s_waitcnt lgkmcnt(0)
    s_mov_b32 s12, s4
    s_and_b32 s13, s5, 0xffff
    s_mov_b32 s14, 29360128
    s_mov_b32 s15, 0x20000
    buffer_load_dwordx4 v[60:63], v1, s[12:15], 0 offen offset:0 nt
    buffer_load_dwordx4 v[68:71], v1, s[12:15], 0 offen offset:896 nt
    buffer_load_dwordx4 v[76:79], v1, s[12:15], 0 offen offset:1792 nt
    buffer_load_dwordx4 v[84:87], v1, s[12:15], 0 offen offset:2688 nt
    buffer_load_dwordx4 v[92:95], v1, s[12:15], s31 offen offset:0 nt
    buffer_load_dwordx4 v[100:103], v1, s[12:15], s31 offen offset:896 nt
    buffer_load_dwordx4 v[108:111], v1, s[12:15], s31 offen offset:1792 nt
    buffer_load_dwordx4 v[116:119], v1, s[12:15], s31 offen offset:2688 nt
    s_mov_b32 s20, s6
    s_and_b32 s21, s7, 0xffff
    s_mov_b32 s22, 896
    s_mov_b32 s23, 0x20000
    s_mov_b32 s24, s8
    s_and_b32 s25, s9, 0xffff
    s_mov_b32 s26, 896
    s_mov_b32 s27, 0x20000
    s_mov_b32 s16, s10
    s_and_b32 s17, s11, 0xffff
    s_mov_b32 s18, 29360128
    s_mov_b32 s19, 0x20000
    buffer_load_dwordx4 v[48:51], v2, s[20:23], 0 offen
    buffer_load_dwordx4 v[52:55], v2, s[24:27], 0 offen
    s_setprio 0
    s_mov_b32 s28, 0xffff0000
    s_waitcnt vmcnt(9)
    v_lshlrev_b32 v56, 16, v60
    v_and_b32 v57, s28, v60
    v_lshlrev_b32 v58, 16, v61
    v_and_b32 v59, s28, v61
    v_lshlrev_b32 v60, 16, v62
    v_and_b32 v61, s28, v62
    v_lshlrev_b32 v62, 16, v63
    v_and_b32 v63, s28, v63
    v_pk_mul_f32 v[8:9], v[56:57], v[56:57]
    v_pk_mul_f32 v[10:11], v[58:59], v[58:59]
    v_pk_mul_f32 v[12:13], v[60:61], v[60:61]
    v_pk_mul_f32 v[14:15], v[62:63], v[62:63]
    s_waitcnt vmcnt(8)
    v_lshlrev_b32 v64, 16, v68
    v_and_b32 v65, s28, v68
    v_lshlrev_b32 v66, 16, v69
    v_and_b32 v67, s28, v69
    v_lshlrev_b32 v68, 16, v70
    v_and_b32 v69, s28, v70
    v_lshlrev_b32 v70, 16, v71
    v_and_b32 v71, s28, v71
    v_pk_fma_f32 v[8:9], v[64:65], v[64:65], v[8:9]
    v_pk_fma_f32 v[10:11], v[66:67], v[66:67], v[10:11]
    v_pk_fma_f32 v[12:13], v[68:69], v[68:69], v[12:13]
    v_pk_fma_f32 v[14:15], v[70:71], v[70:71], v[14:15]
    s_waitcnt vmcnt(7)
    v_lshlrev_b32 v72, 16, v76
    v_and_b32 v73, s28, v76
    v_lshlrev_b32 v74, 16, v77
    v_and_b32 v75, s28, v77
    v_lshlrev_b32 v76, 16, v78
    v_and_b32 v77, s28, v78
    v_lshlrev_b32 v78, 16, v79
    v_and_b32 v79, s28, v79
    v_pk_fma_f32 v[8:9], v[72:73], v[72:73], v[8:9]
    v_pk_fma_f32 v[10:11], v[74:75], v[74:75], v[10:11]
    v_pk_fma_f32 v[12:13], v[76:77], v[76:77], v[12:13]
    v_pk_fma_f32 v[14:15], v[78:79], v[78:79], v[14:15]
    s_waitcnt vmcnt(6)
    v_lshlrev_b32 v80, 16, v84
    v_and_b32 v81, s28, v84
    v_lshlrev_b32 v82, 16, v85
    v_and_b32 v83, s28, v85
    v_lshlrev_b32 v84, 16, v86
    v_and_b32 v85, s28, v86
    v_lshlrev_b32 v86, 16, v87
    v_and_b32 v87, s28, v87
    v_pk_fma_f32 v[8:9], v[80:81], v[80:81], v[8:9]
    v_pk_fma_f32 v[10:11], v[82:83], v[82:83], v[10:11]
    v_pk_fma_f32 v[12:13], v[84:85], v[84:85], v[12:13]
    v_pk_fma_f32 v[14:15], v[86:87], v[86:87], v[14:15]
    s_waitcnt vmcnt(5)
    v_lshlrev_b32 v88, 16, v92
    v_and_b32 v89, s28, v92
    v_lshlrev_b32 v90, 16, v93
    v_and_b32 v91, s28, v93
    v_lshlrev_b32 v92, 16, v94
    v_and_b32 v93, s28, v94
    v_lshlrev_b32 v94, 16, v95
    v_and_b32 v95, s28, v95
    v_pk_fma_f32 v[8:9], v[88:89], v[88:89], v[8:9]
    v_pk_fma_f32 v[10:11], v[90:91], v[90:91], v[10:11]
    v_pk_fma_f32 v[12:13], v[92:93], v[92:93], v[12:13]
    v_pk_fma_f32 v[14:15], v[94:95], v[94:95], v[14:15]
    s_waitcnt vmcnt(4)
    v_lshlrev_b32 v96, 16, v100
    v_and_b32 v97, s28, v100
    v_lshlrev_b32 v98, 16, v101
    v_and_b32 v99, s28, v101
    v_lshlrev_b32 v100, 16, v102
    v_and_b32 v101, s28, v102
    v_lshlrev_b32 v102, 16, v103
    v_and_b32 v103, s28, v103
    v_pk_fma_f32 v[8:9], v[96:97], v[96:97], v[8:9]
    v_pk_fma_f32 v[10:11], v[98:99], v[98:99], v[10:11]
    v_pk_fma_f32 v[12:13], v[100:101], v[100:101], v[12:13]
    v_pk_fma_f32 v[14:15], v[102:103], v[102:103], v[14:15]
    s_waitcnt vmcnt(3)
    v_lshlrev_b32 v104, 16, v108
    v_and_b32 v105, s28, v108
    v_lshlrev_b32 v106, 16, v109
    v_and_b32 v107, s28, v109
    v_lshlrev_b32 v108, 16, v110
    v_and_b32 v109, s28, v110
    v_lshlrev_b32 v110, 16, v111
    v_and_b32 v111, s28, v111
    v_pk_fma_f32 v[8:9], v[104:105], v[104:105], v[8:9]
    v_pk_fma_f32 v[10:11], v[106:107], v[106:107], v[10:11]
    v_pk_fma_f32 v[12:13], v[108:109], v[108:109], v[12:13]
    v_pk_fma_f32 v[14:15], v[110:111], v[110:111], v[14:15]
    s_waitcnt vmcnt(2)
    v_lshlrev_b32 v112, 16, v116
    v_and_b32 v113, s28, v116
    v_lshlrev_b32 v114, 16, v117
    v_and_b32 v115, s28, v117
    v_lshlrev_b32 v116, 16, v118
    v_and_b32 v117, s28, v118
    v_lshlrev_b32 v118, 16, v119
    v_and_b32 v119, s28, v119
    v_pk_fma_f32 v[8:9], v[112:113], v[112:113], v[8:9]
    v_pk_fma_f32 v[10:11], v[114:115], v[114:115], v[10:11]
    v_pk_fma_f32 v[12:13], v[116:117], v[116:117], v[12:13]
    v_pk_fma_f32 v[14:15], v[118:119], v[118:119], v[14:15]
    ds_write_b128 v5, v[8:11]
    ds_write_b128 v5, v[12:15] offset:896
    s_waitcnt lgkmcnt(0)
    s_barrier
    ds_read_b128 v[16:19], v2 offset:0
    ds_read_b128 v[20:23], v2 offset:896
    ds_read_b128 v[24:27], v2 offset:1792
    ds_read_b128 v[28:31], v2 offset:2688
    ds_read_b128 v[32:35], v2 offset:3584
    ds_read_b128 v[36:39], v2 offset:4480
    ds_read_b128 v[40:43], v2 offset:5376
    ds_read_b128 v[44:47], v2 offset:6272
    s_waitcnt lgkmcnt(4)
    v_pk_add_f32 v[16:17], v[16:17], v[24:25]
    v_pk_add_f32 v[18:19], v[18:19], v[26:27]
    v_pk_add_f32 v[20:21], v[20:21], v[28:29]
    v_pk_add_f32 v[22:23], v[22:23], v[30:31]
    s_waitcnt lgkmcnt(0)
    v_pk_add_f32 v[32:33], v[32:33], v[40:41]
    v_pk_add_f32 v[34:35], v[34:35], v[42:43]
    v_pk_add_f32 v[36:37], v[36:37], v[44:45]
    v_pk_add_f32 v[38:39], v[38:39], v[46:47]
    v_pk_add_f32 v[8:9], v[16:17], v[32:33]
    v_pk_add_f32 v[10:11], v[18:19], v[34:35]
    v_pk_add_f32 v[12:13], v[20:21], v[36:37]
    v_pk_add_f32 v[14:15], v[22:23], v[38:39]
    v_sqrt_f32 v8, v8
    v_sqrt_f32 v9, v9
    v_sqrt_f32 v10, v10
    v_sqrt_f32 v11, v11
    v_sqrt_f32 v12, v12
    v_sqrt_f32 v13, v13
    v_sqrt_f32 v14, v14
    v_sqrt_f32 v15, v15
    s_waitcnt vmcnt(0)
    v_lshlrev_b32 v16, 16, v48
    v_and_b32 v17, s28, v48
    v_lshlrev_b32 v18, 16, v49
    v_and_b32 v19, s28, v49
    v_lshlrev_b32 v20, 16, v50
    v_and_b32 v21, s28, v50
    v_lshlrev_b32 v22, 16, v51
    v_and_b32 v23, s28, v51
    v_lshlrev_b32 v24, 16, v52
    v_and_b32 v25, s28, v52
    v_lshlrev_b32 v26, 16, v53
    v_and_b32 v27, s28, v53
    v_lshlrev_b32 v28, 16, v54
    v_and_b32 v29, s28, v54
    v_lshlrev_b32 v30, 16, v55
    v_and_b32 v31, s28, v55
    v_add_f32 v32, v8, v9
    v_add_f32 v33, v10, v11
    v_add_f32 v34, v12, v13
    v_add_f32 v35, v14, v15
    v_add_f32 v32, v32, v33
    v_add_f32 v34, v34, v35
    v_add_f32 v3, v32, v34
    s_mov_b64 exec, -1
    v_mul_f32 v16, v16, v8
    v_mul_f32 v17, v17, v9
    v_add_f32_dpp v3, v3, v3 row_shr:1 row_mask:0xf bank_mask:0xf bound_ctrl:1
    v_mul_f32 v18, v18, v10
    v_mul_f32 v19, v19, v11
    v_add_f32_dpp v3, v3, v3 row_shr:2 row_mask:0xf bank_mask:0xf bound_ctrl:1
    v_mul_f32 v20, v20, v12
    v_mul_f32 v21, v21, v13
    v_add_f32_dpp v3, v3, v3 row_shr:4 row_mask:0xf bank_mask:0xf bound_ctrl:1
    v_mul_f32 v22, v22, v14
    v_mul_f32 v23, v23, v15
    v_add_f32_dpp v3, v3, v3 row_shr:8 row_mask:0xf bank_mask:0xf bound_ctrl:1
    s_nop 0
    s_nop 0
    v_add_f32_dpp v3, v3, v3 row_bcast:15 row_mask:0xa bank_mask:0xf
    s_nop 0
    s_nop 0
    v_add_f32_dpp v3, v3, v3 row_bcast:31 row_mask:0xc bank_mask:0xf
    v_fmaak_f32 v3, v3, v4, 0x358637bd
    v_rcp_f32 v3, v3
    s_nop 0
    s_setprio 2
    v_readlane_b32 s29, v3, 63
    s_mov_b32 exec_lo, -1
    s_mov_b32 exec_hi, 0x00ffffff
    s_nop 0
    v_fma_f32 v16, v16, s29, 1.0
    v_fma_f32 v17, v17, s29, 1.0
    v_fma_f32 v18, v18, s29, 1.0
    v_fma_f32 v19, v19, s29, 1.0
    v_fma_f32 v20, v20, s29, 1.0
    v_fma_f32 v21, v21, s29, 1.0
    v_fma_f32 v22, v22, s29, 1.0
    v_fma_f32 v23, v23, s29, 1.0
    v_pk_fma_f32 v[56:57], v[56:57], v[16:17], v[24:25]
    v_pk_fma_f32 v[58:59], v[58:59], v[18:19], v[26:27]
    v_pk_fma_f32 v[60:61], v[60:61], v[20:21], v[28:29]
    v_pk_fma_f32 v[62:63], v[62:63], v[22:23], v[30:31]
    v_cvt_pk_bf16_f32 v56, v56, v57
    v_cvt_pk_bf16_f32 v57, v58, v59
    v_cvt_pk_bf16_f32 v58, v60, v61
    v_cvt_pk_bf16_f32 v59, v62, v63
    buffer_store_dwordx4 v[56:59], v1, s[16:19], 0 offen offset:0 nt
    v_pk_fma_f32 v[64:65], v[64:65], v[16:17], v[24:25]
    v_pk_fma_f32 v[66:67], v[66:67], v[18:19], v[26:27]
    v_pk_fma_f32 v[68:69], v[68:69], v[20:21], v[28:29]
    v_pk_fma_f32 v[70:71], v[70:71], v[22:23], v[30:31]
    v_cvt_pk_bf16_f32 v64, v64, v65
    v_cvt_pk_bf16_f32 v65, v66, v67
    v_cvt_pk_bf16_f32 v66, v68, v69
    v_cvt_pk_bf16_f32 v67, v70, v71
    buffer_store_dwordx4 v[64:67], v1, s[16:19], 0 offen offset:896 nt
    v_pk_fma_f32 v[72:73], v[72:73], v[16:17], v[24:25]
    v_pk_fma_f32 v[74:75], v[74:75], v[18:19], v[26:27]
    v_pk_fma_f32 v[76:77], v[76:77], v[20:21], v[28:29]
    v_pk_fma_f32 v[78:79], v[78:79], v[22:23], v[30:31]
    v_cvt_pk_bf16_f32 v72, v72, v73
    v_cvt_pk_bf16_f32 v73, v74, v75
    v_cvt_pk_bf16_f32 v74, v76, v77
    v_cvt_pk_bf16_f32 v75, v78, v79
    buffer_store_dwordx4 v[72:75], v1, s[16:19], 0 offen offset:1792 nt
    v_pk_fma_f32 v[80:81], v[80:81], v[16:17], v[24:25]
    v_pk_fma_f32 v[82:83], v[82:83], v[18:19], v[26:27]
    v_pk_fma_f32 v[84:85], v[84:85], v[20:21], v[28:29]
    v_pk_fma_f32 v[86:87], v[86:87], v[22:23], v[30:31]
    v_cvt_pk_bf16_f32 v80, v80, v81
    v_cvt_pk_bf16_f32 v81, v82, v83
    v_cvt_pk_bf16_f32 v82, v84, v85
    v_cvt_pk_bf16_f32 v83, v86, v87
    buffer_store_dwordx4 v[80:83], v1, s[16:19], 0 offen offset:2688 nt
    v_pk_fma_f32 v[88:89], v[88:89], v[16:17], v[24:25]
    v_pk_fma_f32 v[90:91], v[90:91], v[18:19], v[26:27]
    v_pk_fma_f32 v[92:93], v[92:93], v[20:21], v[28:29]
    v_pk_fma_f32 v[94:95], v[94:95], v[22:23], v[30:31]
    v_cvt_pk_bf16_f32 v88, v88, v89
    v_cvt_pk_bf16_f32 v89, v90, v91
    v_cvt_pk_bf16_f32 v90, v92, v93
    v_cvt_pk_bf16_f32 v91, v94, v95
    buffer_store_dwordx4 v[88:91], v1, s[16:19], s31 offen offset:0 nt
    v_pk_fma_f32 v[96:97], v[96:97], v[16:17], v[24:25]
    v_pk_fma_f32 v[98:99], v[98:99], v[18:19], v[26:27]
    v_pk_fma_f32 v[100:101], v[100:101], v[20:21], v[28:29]
    v_pk_fma_f32 v[102:103], v[102:103], v[22:23], v[30:31]
    v_cvt_pk_bf16_f32 v96, v96, v97
    v_cvt_pk_bf16_f32 v97, v98, v99
    v_cvt_pk_bf16_f32 v98, v100, v101
    v_cvt_pk_bf16_f32 v99, v102, v103
    buffer_store_dwordx4 v[96:99], v1, s[16:19], s31 offen offset:896 nt
    v_pk_fma_f32 v[104:105], v[104:105], v[16:17], v[24:25]
    v_pk_fma_f32 v[106:107], v[106:107], v[18:19], v[26:27]
    v_pk_fma_f32 v[108:109], v[108:109], v[20:21], v[28:29]
    v_pk_fma_f32 v[110:111], v[110:111], v[22:23], v[30:31]
    v_cvt_pk_bf16_f32 v104, v104, v105
    v_cvt_pk_bf16_f32 v105, v106, v107
    v_cvt_pk_bf16_f32 v106, v108, v109
    v_cvt_pk_bf16_f32 v107, v110, v111
    buffer_store_dwordx4 v[104:107], v1, s[16:19], s31 offen offset:1792 nt
    v_pk_fma_f32 v[112:113], v[112:113], v[16:17], v[24:25]
    v_pk_fma_f32 v[114:115], v[114:115], v[18:19], v[26:27]
    v_pk_fma_f32 v[116:117], v[116:117], v[20:21], v[28:29]
    v_pk_fma_f32 v[118:119], v[118:119], v[22:23], v[30:31]
    v_cvt_pk_bf16_f32 v112, v112, v113
    v_cvt_pk_bf16_f32 v113, v114, v115
    v_cvt_pk_bf16_f32 v114, v116, v117
    v_cvt_pk_bf16_f32 v115, v118, v119
    buffer_store_dwordx4 v[112:115], v1, s[16:19], s31 offen offset:2688 nt
L_end:
    s_endpgm
.section .rodata,"a"
.p2align 6
.amdhsa_kernel standalone__grn__sampling_kernel
  .amdhsa_next_free_vgpr 120
  .amdhsa_next_free_sgpr 48
  .amdhsa_accum_offset 120
  .amdhsa_float_denorm_mode_32 3
  .amdhsa_group_segment_fixed_size 0
  .amdhsa_kernarg_size 48
  .amdhsa_user_sgpr_count 2
  .amdhsa_user_sgpr_kernarg_segment_ptr 1
  .amdhsa_system_sgpr_workgroup_id_x 1
.end_amdhsa_kernel
```
